```python
import torch

def _softmax(x, axis=-1):
    return torch.softmax(x, dim=axis)
def _gelu(x):
    return torch.nn.functional.gelu(x, approximate="tanh")
def _silu(x):
    return torch.nn.functional.silu(x)
def _sigmoid(x):
    return torch.sigmoid(x)
def _layernorm(x, axis=-1, eps=1e-5):
    m = x.mean(dim=axis, keepdim=True)
    v = x.var(dim=axis, keepdim=True, unbiased=False)
    return (x - m) / torch.sqrt(v + eps)
def _scatter_add(tgt, idx, src, axis=0):
    return tgt.clone().index_add_(axis, idx, src)
def _segment_sum(src, seg, n):
    out = torch.zeros((n,) + src.shape[1:], dtype=src.dtype)
    return out.index_add_(0, seg, src)
def _pad(x, pw):
    flat = tuple(v for pair in reversed(pw) for v in pair)
    return torch.nn.functional.pad(x, flat)

kernel_name = 'standalone__fused_io_aware_attn__prompt'

def setup_inputs():

    _w = (lambda a: (lambda t: t.to(torch.bfloat16) if t.is_floating_point() else t)(torch.as_tensor(a)))
    B, H, S = 1, 32, 2048
    Dh = max(1, 640 // 32)
    return {
        "q": _w((lambda *s: torch.randn(*s, dtype=torch.bfloat16) * 0.8)(B, H, S, Dh)),
        "k": _w((lambda *s: torch.randn(*s, dtype=torch.bfloat16) * 0.8)(B, H, S, Dh)),
        "v": _w((lambda *s: torch.randn(*s, dtype=torch.bfloat16) * 0.05)(B, H, S, Dh)),
    }

def reference(q, k, v):
    scale = q.shape[-1] ** -0.5
    s = torch.einsum('bhqd,bhkd->bhqk', q, k) * scale
    p = _softmax(s, axis=-1)
    return torch.einsum('bhqk,bhkd->bhqd', p, v)
```

```asm
; @launch grid=(256,1,1) block=(512,1,1) lds=148704

.amdgcn_target "amdgcn-amd-amdhsa--gfx950"
.text
.globl standalone__fused_io_aware_attn__prompt_kernel
.p2align 12
.fill 832, 4, 0xbf810000
.p2align 8
.type standalone__fused_io_aware_attn__prompt_kernel,@function
standalone__fused_io_aware_attn__prompt_kernel:
    s_load_dwordx4 s[4:7], s[0:1], 8
    s_load_dwordx2 s[12:13], s[0:1], 0
    s_load_dwordx2 s[20:21], s[0:1], 24
    v_readfirstlane_b32 s33, v0
    s_cmp_ge_u32 s2, 256
    s_cbranch_scc1 L_END
    v_and_b32 v145, 63, v0
    v_and_b32 v146, 31, v0
    v_bfe_u32 v147, v0, 5, 1
    s_lshr_b32 s33, s33, 6
    s_and_b32 s40, s2, 7
    s_lshr_b32 s41, s2, 6
    s_lshl2_add_u32 s40, s40, s41
    s_mov_b32 s45, 81920
    s_mul_i32 s34, s40, s45
    s_and_b32 s49, s2, 0x38
    s_add_u32 s49, s49, s33
    s_mulk_i32 s49, 1280
    s_add_u32 s46, s49, s34
    v_mul_u32_u24 v152, 40, v146
    v_lshl_add_u32 v152, v147, 4, v152
    v_add_u32 v156, s46, v152
    v_lshl_add_u32 v155, v145, 4, s34
    v_mov_b32 v104, 0x4234
    v_mov_b32 v105, 0
    s_and_b32 s42, s33, 3
    s_lshl_b32 s37, s42, 10
    s_lshr_b32 s38, s33, 2
    s_mul_i32 s43, s38, s45
    s_add_u32 m0, s43, s37
    s_mov_b32 s14, 2621440
    s_mov_b32 s15, 0x00020000
    s_mov_b64 s[18:19], s[14:15]
    s_mov_b64 s[26:27], s[14:15]
    s_cmp_eq_u32 s33, 3
    s_cselect_b32 s44, 0x1000, s37
    s_cselect_b32 s43, 0, s45
    s_add_u32 s43, s43, s44
    s_mov_b32 s39, 143360
    s_cmp_lg_u32 s38, 0
    s_cbranch_scc1 L_SETUP
    s_setprio 3
    s_cmp_eq_u32 s33, 3
    s_waitcnt lgkmcnt(0)
    s_mov_b64 s[16:17], s[4:5]
    buffer_load_dwordx4 v155, s[16:19], s37 offen lds
    s_cselect_b64 s[24:25], s[4:5], s[6:7]
    s_mov_b32 m0, s43
    s_addk_i32 s37, 4096
    buffer_load_dwordx4 v155, s[24:27], s44 offen lds
    s_mov_b32 exec_hi, 0
    buffer_load_dwordx2 v[104:105], v156, s[12:15], 0 offen offset:32
    s_mov_b32 exec_hi, -1
    buffer_load_dwordx4 v[96:99], v156, s[12:15], 0 offen
    s_barrier
    s_mov_b32 m0, s37
    s_mov_b32 s39, -1
    buffer_load_dwordx4 v155, s[16:19], s37 offen lds
    s_addk_i32 m0, 4096
    s_addk_i32 s37, 4096
L_SETUP:
    s_movk_i32 s36, 554
    s_mov_b64 s[22:23], s[14:15]
    v_bfe_u32 v148, v0, 1, 3
    v_and_b32 v149, 1, v0
    v_lshl_add_u32 v148, v148, 2, v149
    s_mov_b32 s47, 143584
    v_mul_u32_u24 v148, 160, v148
    v_add_u32 v148, s47, v148
    v_mov_b32 v32, 0x3f80
    v_mov_b32 v33, 0
    v_mov_b64 v[34:35], 0
    ds_write_b128 v148, v[32:35]
    v_mov_b32 v154, 0xdddddddd
    v_mfma_f32_32x32x4_2b_bf16 v[64:95], v[34:35], v[34:35], 0
    v_mov_b64 v[116:117], v[32:33]
    v_mov_b64 v[118:119], v[32:33]
    v_mov_b64 v[140:141], v[32:33]
    v_mov_b64 v[142:143], v[32:33]
    v_bfe_u32 v148, v0, 2, 2
    v_lshl_add_u32 v148, v147, 3, v148
    v_mul_u32_u24 v148, 40, v148
    v_lshl_add_u32 v148, v149, 4, v148
    v_and_b32 v150, 2, v0
    v_lshl_add_u32 v148, v150, 2, v148
    v_and_b32 v149, 16, v0
    v_lshl_add_u32 v148, v149, 1, v148
    v_add_u32 v148, s45, v148
    v_and_b32 v149, 19, v0
    v_cmp_lt_u32 vcc, 16, v149
    v_lshl_add_u32 v150, v150, 2, s47
    s_mul_i32 s43, s38, 1280
    s_addk_i32 s43, 5120
    v_cndmask_b32 v153, v148, v150, vcc
    v_add_u32 v149, s43, v148
    v_add_u32 v136, s43, v152
    v_cndmask_b32 v137, v149, v150, vcc
    v_add_u32 v148, 17920, v148
    v_mov_b32 v138, 5120
    v_cndmask_b32 v160, v148, v150, vcc
    s_lshl_b32 s43, s33, 12
    v_cndmask_b32 v139, v138, 0, vcc
    v_lshl_add_u32 v158, v145, 4, s43
    s_xor_b32 s43, s43, 0x4000
    v_lshlrev_b32 v163, 2, v145
    v_add_u32 v159, 79360, v152
    s_mov_b32 s35, 1
    s_mov_b32 s40, 0x3ea52b5c
    s_mov_b32 s41, 0xffff0000
    s_cmp_eq_u32 s38, 0
    s_cbranch_scc1 L_R2
    s_setprio 2
    s_waitcnt lgkmcnt(0)
    s_mov_b64 s[16:17], s[6:7]
    s_cmp_lg_u32 s33, 7
    s_cbranch_scc1 L_NR0
    buffer_load_dwordx4 v155, s[16:19], s37 offen lds
L_NR0:
    s_addk_i32 m0, 4096
    s_addk_i32 s37, 4096
    s_barrier
    s_mov_b32 exec_hi, 0
    buffer_load_dwordx2 v[104:105], v156, s[12:15], 0 offen offset:32
    s_mov_b32 exec_hi, -1
    buffer_load_dwordx4 v[96:99], v156, s[12:15], 0 offen
    buffer_load_dwordx4 v155, s[16:19], s37 offen lds
    s_addk_i32 m0, 4096
    s_addk_i32 s37, 4096
L_R2:
    buffer_load_dwordx4 v155, s[16:19], s37 offen lds
    s_addk_i32 m0, 4096
    s_addk_i32 s37, 4096
    buffer_load_dwordx4 v155, s[16:19], s37 offen lds
    s_addk_i32 m0, 4096
    s_addk_i32 s37, 4096
    s_cmp_eq_u32 s38, 0
    s_waitcnt lgkmcnt(0)
    s_cbranch_scc1 L_B0
    s_barrier
    v_xor_b32 v157, 0x4000, v158
    v_add_u32 v161, s43, v152
    v_add_u32 v162, s43, v163
    ds_read_b64 v[108:109], v152 offset:2560
    ds_read_b64 v[110:111], v152 offset:2568
    ds_read_b64 v[112:113], v152 offset:3840
    ds_read_b64 v[114:115], v152 offset:3848
    ds_read_b64_tr_b16 v[120:121], v153 offset:0
    ds_read_b64_tr_b16 v[122:123], v153 offset:160
    ds_read_b64_tr_b16 v[124:125], v153 offset:640
    ds_read_b64_tr_b16 v[126:127], v153 offset:800
    ds_read_b64_tr_b16 v[128:129], v153 offset:1280
    ds_read_b64_tr_b16 v[130:131], v153 offset:1440
    ds_read_b64_tr_b16 v[132:133], v153 offset:1920
    ds_read_b64_tr_b16 v[134:135], v153 offset:2080
    s_branch L_K0
L_B0:
    v_xor_b32 v157, 0x4000, v158
    v_add_u32 v161, s43, v152
    v_add_u32 v162, s43, v163
    s_waitcnt vmcnt(5)
    s_barrier
L_K0:
    ds_read_b64 v[32:33], v152 offset:0
    ds_read_b64 v[34:35], v152 offset:8
    ds_read_b64 v[36:37], v152 offset:1280
    ds_read_b64 v[38:39], v152 offset:1288
    s_mov_b32 exec_hi, 0
    ds_read2_b64 v[140:143], v152 offset0:4 offset1:164
    ds_read_b64 v[116:117], v152 offset:2592
    ds_read_b64 v[118:119], v152 offset:3872
    s_waitcnt vmcnt(4)
    v_lshlrev_b32 v144, 16, v104
    v_and_b32 v145, s41, v104
    v_lshlrev_b32 v146, 16, v105
    v_and_b32 v147, s41, v105
    v_mul_f32 v144, s40, v144
    v_mul_f32 v145, s40, v145
    v_mul_f32 v146, s40, v146
    v_mul_f32 v147, s40, v147
    v_cvt_pk_bf16_f32 v104, v144, v145
    v_cvt_pk_bf16_f32 v105, v146, v147
    s_mov_b32 exec_hi, -1
    s_waitcnt vmcnt(3) lgkmcnt(2)
    v_mfma_f32_32x32x8_bf16 v[0:15], v[140:141], v[104:105], 0
    v_lshlrev_b32 v144, 16, v96
    v_and_b32 v145, s41, v96
    v_lshlrev_b32 v146, 16, v97
    v_and_b32 v147, s41, v97
    v_lshlrev_b32 v148, 16, v98
    v_and_b32 v149, s41, v98
    v_lshlrev_b32 v150, 16, v99
    v_and_b32 v151, s41, v99
    v_mul_f32 v144, s40, v144
    v_mul_f32 v145, s40, v145
    v_mul_f32 v146, s40, v146
    v_mul_f32 v147, s40, v147
    v_mul_f32 v148, s40, v148
    v_mul_f32 v149, s40, v149
    v_mul_f32 v150, s40, v150
    v_mul_f32 v151, s40, v151
    v_cvt_pk_bf16_f32 v96, v144, v145
    v_cvt_pk_bf16_f32 v97, v146, v147
    v_cvt_pk_bf16_f32 v98, v148, v149
    v_cvt_pk_bf16_f32 v99, v150, v151
    s_cmp_lg_u32 s38, 0
    s_waitcnt lgkmcnt(0)
    v_mfma_f32_32x32x16_bf16 v[0:15], v[32:35], v[96:99], v[0:15]
    s_cbranch_scc1 L_FGO
    ds_read_b64 v[108:109], v152 offset:2560
    ds_read_b64 v[110:111], v152 offset:2568
    ds_read_b64 v[112:113], v152 offset:3840
    ds_read_b64 v[114:115], v152 offset:3848
    v_mfma_f32_32x32x8_bf16 v[16:31], v[142:143], v[104:105], 0
    ds_read_b64_tr_b16 v[120:121], v153 offset:0
    ds_read_b64_tr_b16 v[122:123], v153 offset:160
    ds_read_b64_tr_b16 v[124:125], v153 offset:640
    ds_read_b64_tr_b16 v[126:127], v153 offset:800
    ds_read_b64_tr_b16 v[128:129], v153 offset:1280
    ds_read_b64_tr_b16 v[130:131], v153 offset:1440
    v_exp_f32 v0, v0
    ds_read_b64_tr_b16 v[132:133], v153 offset:1920
    ds_read_b64_tr_b16 v[134:135], v153 offset:2080
    s_setprio 1
    v_mfma_f32_32x32x16_bf16 v[16:31], v[36:39], v[96:99], v[16:31]
    v_exp_f32 v1, v1
    v_exp_f32 v2, v2
    v_exp_f32 v3, v3
    v_exp_f32 v4, v4
    v_mfma_f32_32x32x8_bf16 v[32:47], v[116:117], v[104:105], 0
    v_exp_f32 v5, v5
    v_exp_f32 v6, v6
    v_exp_f32 v7, v7
    v_exp_f32 v8, v8
    v_mfma_f32_32x32x8_bf16 v[48:63], v[118:119], v[104:105], 0
    v_exp_f32 v9, v9
    v_exp_f32 v10, v10
    v_exp_f32 v11, v11
    v_exp_f32 v12, v12
    s_waitcnt lgkmcnt(0)
    v_smfmac_f32_32x32x32_bf16 v[64:79], v[120:123], v[0:7], v154
    v_exp_f32 v13, v13
    v_exp_f32 v14, v14
    v_exp_f32 v15, v15
    v_mfma_f32_32x32x16_bf16 v[32:47], v[108:111], v[96:99], v[32:47]
    v_exp_f32 v16, v16
    v_exp_f32 v17, v17
    v_exp_f32 v18, v18
    v_mfma_f32_32x32x16_bf16 v[48:63], v[112:115], v[96:99], v[48:63]
    v_exp_f32 v19, v19
    v_exp_f32 v20, v20
    v_exp_f32 v21, v21
    v_smfmac_f32_32x32x32_bf16 v[64:79], v[124:127], v[8:15], v154
    v_exp_f32 v22, v22
    v_exp_f32 v23, v23
    v_exp_f32 v24, v24
    v_exp_f32 v25, v25
    v_exp_f32 v26, v26
    v_exp_f32 v27, v27
    v_exp_f32 v28, v28
    v_exp_f32 v29, v29
    v_exp_f32 v30, v30
    v_exp_f32 v31, v31
    v_smfmac_f32_32x32x32_bf16 v[64:79], v[128:131], v[16:23], v154
    s_waitcnt vmcnt(2)
    s_barrier
    v_smfmac_f32_32x32x32_bf16 v[64:79], v[132:135], v[24:31], v154
    s_setprio 0
    buffer_load_dwordx4 v155, s[16:19], s37 offen lds
    s_addk_i32 m0, 4096
    s_addk_i32 s37, 4096
    ds_write_b128 v158, v[96:99] offset:49152
    ds_write_b64 v158, v[104:105] offset:50176
    s_branch L_OFF1
L_FGO:
    v_mfma_f32_32x32x8_bf16 v[16:31], v[142:143], v[104:105], 0
    ds_write_b128 v158, v[96:99] offset:49152
    ds_write_b64 v158, v[104:105] offset:50176
    buffer_load_dwordx4 v155, s[16:19], s37 offen lds
    s_addk_i32 m0, 4096
    s_addk_i32 s37, 4096
    s_nop 4
    v_mfma_f32_32x32x16_bf16 v[16:31], v[36:39], v[96:99], v[16:31]
    s_setprio 0
    s_waitcnt vmcnt(3) lgkmcnt(0)
    s_barrier
    v_exp_f32 v0, v0
    s_setprio 1
    v_exp_f32 v1, v1
    v_exp_f32 v2, v2
    v_exp_f32 v3, v3
    v_exp_f32 v4, v4
    v_mfma_f32_32x32x8_bf16 v[32:47], v[116:117], v[104:105], 0
    v_exp_f32 v5, v5
    v_exp_f32 v6, v6
    v_exp_f32 v7, v7
    v_exp_f32 v8, v8
    v_mfma_f32_32x32x8_bf16 v[48:63], v[118:119], v[104:105], 0
    v_exp_f32 v9, v9
    v_exp_f32 v10, v10
    v_exp_f32 v11, v11
    v_exp_f32 v12, v12
    v_smfmac_f32_32x32x32_bf16 v[64:79], v[120:123], v[0:7], v154
    v_exp_f32 v13, v13
    v_exp_f32 v14, v14
    v_exp_f32 v15, v15
    v_mfma_f32_32x32x16_bf16 v[32:47], v[108:111], v[96:99], v[32:47]
    v_exp_f32 v16, v16
    v_exp_f32 v17, v17
    v_exp_f32 v18, v18
    v_mfma_f32_32x32x16_bf16 v[48:63], v[112:115], v[96:99], v[48:63]
    v_exp_f32 v19, v19
    v_exp_f32 v20, v20
    v_exp_f32 v21, v21
    v_smfmac_f32_32x32x32_bf16 v[64:79], v[124:127], v[8:15], v154
    v_exp_f32 v22, v22
    v_exp_f32 v23, v23
    v_exp_f32 v24, v24
    v_exp_f32 v25, v25
    v_exp_f32 v26, v26
    v_exp_f32 v27, v27
    v_exp_f32 v28, v28
    v_exp_f32 v29, v29
    v_exp_f32 v30, v30
    v_exp_f32 v31, v31
    v_smfmac_f32_32x32x32_bf16 v[64:79], v[128:131], v[16:23], v154
    s_barrier
    v_smfmac_f32_32x32x32_bf16 v[64:79], v[132:135], v[24:31], v154
    s_setprio 0
L_OFF1:
    s_mov_b32 exec_hi, 0
    ds_read_b64 v[116:117], v136 offset:32
    s_mov_b32 exec_hi, -1
    ds_read_b64 v[108:109], v136 offset:0
    ds_read_b64 v[110:111], v136 offset:8
    ds_read_b64 v[106:107], v157 offset:50176
    ds_read_b128 v[100:103], v157 offset:49152
    ds_read_b64_tr_b16 v[120:121], v153 offset:2560
    ds_read_b64_tr_b16 v[122:123], v153 offset:2720
    ds_read_b64_tr_b16 v[124:125], v153 offset:3200
    ds_read_b64_tr_b16 v[126:127], v153 offset:3360
    ds_read_b64_tr_b16 v[128:129], v153 offset:3840
    ds_read_b64_tr_b16 v[130:131], v153 offset:4000
    ds_read_b64_tr_b16 v[132:133], v153 offset:4480
    ds_read_b64_tr_b16 v[134:135], v153 offset:4640
    buffer_load_dwordx4 v155, s[16:19], s37 offen lds
    s_addk_i32 m0, 4096
    s_addk_i32 s37, 4096
    s_cmp_lg_u32 s38, 0
    s_waitcnt lgkmcnt(0)
    s_cbranch_scc1 L_BU1
    s_waitcnt vmcnt(3)
    s_barrier
L_BU1:
    v_exp_f32 v32, v32
    s_setprio 1
    v_exp_f32 v33, v33
    v_exp_f32 v34, v34
    v_exp_f32 v35, v35
    v_exp_f32 v36, v36
    v_mfma_f32_32x32x8_bf16 v[0:15], v[116:117], v[104:105], 0
    v_exp_f32 v37, v37
    v_exp_f32 v38, v38
    v_exp_f32 v39, v39
    v_exp_f32 v40, v40
    v_mfma_f32_32x32x8_bf16 v[16:31], v[116:117], v[106:107], 0
    v_exp_f32 v41, v41
    v_exp_f32 v42, v42
    v_exp_f32 v43, v43
    v_exp_f32 v44, v44
    v_smfmac_f32_32x32x32_bf16 v[64:79], v[120:123], v[32:39], v154
    v_exp_f32 v45, v45
    v_exp_f32 v46, v46
    v_exp_f32 v47, v47
    v_mfma_f32_32x32x16_bf16 v[0:15], v[108:111], v[96:99], v[0:15]
    v_exp_f32 v48, v48
    v_exp_f32 v49, v49
    v_exp_f32 v50, v50
    v_mfma_f32_32x32x16_bf16 v[16:31], v[108:111], v[100:103], v[16:31]
    v_exp_f32 v51, v51
    v_exp_f32 v52, v52
    v_exp_f32 v53, v53
    v_smfmac_f32_32x32x32_bf16 v[64:79], v[124:127], v[40:47], v154
    v_exp_f32 v54, v54
    v_exp_f32 v55, v55
    v_exp_f32 v56, v56
    v_exp_f32 v57, v57
    v_smfmac_f32_32x32x32_bf16 v[64:79], v[128:131], v[48:55], v154
    v_exp_f32 v58, v58
    v_exp_f32 v59, v59
    v_exp_f32 v60, v60
    v_exp_f32 v61, v61
    v_exp_f32 v62, v62
    v_exp_f32 v63, v63
    s_nop 1
    v_smfmac_f32_32x32x32_bf16 v[64:79], v[132:135], v[56:63], v154
    s_setprio 0
    s_branch L_LOOP
L_WRAP:
    v_mad_i32_i24 v137, v139, -12, v137
    s_branch L_BURST1
L_BAR:
    v_exp_f32 v0, v0
    s_setprio 1
    v_exp_f32 v1, v1
    v_exp_f32 v2, v2
    v_exp_f32 v3, v3
    v_exp_f32 v4, v4
    v_mfma_f32_32x32x8_bf16 v[32:47], v[116:117], v[104:105], 0
    v_exp_f32 v5, v5
    v_exp_f32 v6, v6
    v_exp_f32 v7, v7
    v_exp_f32 v8, v8
    v_mfma_f32_32x32x8_bf16 v[48:63], v[116:117], v[106:107], 0
    v_exp_f32 v9, v9
    v_exp_f32 v10, v10
    v_exp_f32 v11, v11
    v_exp_f32 v12, v12
    v_smfmac_f32_32x32x32_bf16 v[64:79], v[120:123], v[0:7], v154
    v_exp_f32 v13, v13
    v_exp_f32 v14, v14
    v_exp_f32 v15, v15
    v_mfma_f32_32x32x16_bf16 v[32:47], v[108:111], v[96:99], v[32:47]
    v_exp_f32 v16, v16
    v_exp_f32 v17, v17
    v_exp_f32 v18, v18
    v_mfma_f32_32x32x16_bf16 v[48:63], v[108:111], v[100:103], v[48:63]
    v_exp_f32 v19, v19
    v_exp_f32 v20, v20
    v_exp_f32 v21, v21
    v_smfmac_f32_32x32x32_bf16 v[64:79], v[124:127], v[8:15], v154
    v_exp_f32 v22, v22
    v_exp_f32 v23, v23
    v_exp_f32 v24, v24
    v_exp_f32 v25, v25
    v_exp_f32 v26, v26
    v_exp_f32 v27, v27
    v_exp_f32 v28, v28
    v_exp_f32 v29, v29
    v_exp_f32 v30, v30
    v_exp_f32 v31, v31
    v_smfmac_f32_32x32x32_bf16 v[80:95], v[120:123], v[16:23], v154
    s_waitcnt vmcnt(2)
    s_barrier
    v_smfmac_f32_32x32x32_bf16 v[80:95], v[124:127], v[24:31], v154
    s_setprio 0
    s_branch L_OFFB
L_LOOP:
    s_mov_b32 exec_hi, 0
    ds_read_b64 v[116:117], v136 offset:2592
    s_mov_b32 exec_hi, -1
    ds_read_b64 v[108:109], v136 offset:2560
    ds_read_b64 v[110:111], v136 offset:2568
    ds_read_b64_tr_b16 v[120:121], v137 offset:0
    ds_read_b64_tr_b16 v[122:123], v137 offset:160
    ds_read_b64_tr_b16 v[124:125], v137 offset:640
    ds_read_b64_tr_b16 v[126:127], v137 offset:800
    s_cmp_ge_u32 s37, s45
    s_cbranch_scc1 L_ND0
    buffer_load_dwordx4 v155, s[16:19], s37 offen lds
    s_addk_i32 m0, 4096
    s_addk_i32 s37, 4096
L_ND0:
    s_cmp_ge_u32 m0, s39
    s_cselect_b32 s42, 61440, 0
    s_sub_u32 m0, m0, s42
    s_bitcmp1_b32 s36, s35
    s_waitcnt lgkmcnt(0)
    s_cbranch_scc0 L_BURST0
    s_cmp_lg_u32 s35, 9
    s_cbranch_scc1 L_NT
    s_waitcnt vmcnt(0)
L_NT:
    s_cmp_eq_u32 s38, 0
    s_cbranch_scc1 L_BAR
    s_waitcnt vmcnt(2)
    s_barrier
L_BURST0:
    v_exp_f32 v0, v0
    s_setprio 1
    v_exp_f32 v1, v1
    v_exp_f32 v2, v2
    v_exp_f32 v3, v3
    v_exp_f32 v4, v4
    v_mfma_f32_32x32x8_bf16 v[32:47], v[116:117], v[104:105], 0
    v_exp_f32 v5, v5
    v_exp_f32 v6, v6
    v_exp_f32 v7, v7
    v_exp_f32 v8, v8
    v_mfma_f32_32x32x8_bf16 v[48:63], v[116:117], v[106:107], 0
    v_exp_f32 v9, v9
    v_exp_f32 v10, v10
    v_exp_f32 v11, v11
    v_exp_f32 v12, v12
    v_smfmac_f32_32x32x32_bf16 v[64:79], v[120:123], v[0:7], v154
    v_exp_f32 v13, v13
    v_exp_f32 v14, v14
    v_exp_f32 v15, v15
    v_mfma_f32_32x32x16_bf16 v[32:47], v[108:111], v[96:99], v[32:47]
    v_exp_f32 v16, v16
    v_exp_f32 v17, v17
    v_exp_f32 v18, v18
    v_mfma_f32_32x32x16_bf16 v[48:63], v[108:111], v[100:103], v[48:63]
    v_exp_f32 v19, v19
    v_exp_f32 v20, v20
    v_exp_f32 v21, v21
    v_smfmac_f32_32x32x32_bf16 v[64:79], v[124:127], v[8:15], v154
    v_exp_f32 v22, v22
    v_exp_f32 v23, v23
    v_exp_f32 v24, v24
    v_exp_f32 v25, v25
    v_smfmac_f32_32x32x32_bf16 v[80:95], v[120:123], v[16:23], v154
    v_exp_f32 v26, v26
    v_exp_f32 v27, v27
    v_exp_f32 v28, v28
    v_exp_f32 v29, v29
    v_exp_f32 v30, v30
    v_exp_f32 v31, v31
    s_nop 1
    v_smfmac_f32_32x32x32_bf16 v[80:95], v[124:127], v[24:31], v154
    s_setprio 0
L_OFFB:
    s_mov_b32 exec_hi, 0
    ds_read_b64 v[116:117], v136 offset:5152
    s_mov_b32 exec_hi, -1
    ds_read_b64 v[108:109], v136 offset:5120
    ds_read_b64 v[110:111], v136 offset:5128
    ds_read_b64_tr_b16 v[120:121], v137 offset:2560
    ds_read_b64_tr_b16 v[122:123], v137 offset:2720
    ds_read_b64_tr_b16 v[124:125], v137 offset:3200
    ds_read_b64_tr_b16 v[126:127], v137 offset:3360
    s_cmp_ge_u32 s37, s45
    s_cbranch_scc1 L_ND1
    buffer_load_dwordx4 v155, s[16:19], s37 offen lds
    s_addk_i32 m0, 4096
    s_addk_i32 s37, 4096
L_ND1:
    s_add_u32 s35, s35, 1
    s_cmp_eq_u32 s35, 12
    s_waitcnt lgkmcnt(0)
    s_cbranch_scc1 L_WRAP
L_BURST1:
    v_exp_f32 v32, v32
    s_setprio 1
    v_exp_f32 v33, v33
    v_exp_f32 v34, v34
    v_exp_f32 v35, v35
    v_exp_f32 v36, v36
    v_mfma_f32_32x32x8_bf16 v[0:15], v[116:117], v[104:105], 0
    v_exp_f32 v37, v37
    v_exp_f32 v38, v38
    v_exp_f32 v39, v39
    v_exp_f32 v40, v40
    v_mfma_f32_32x32x8_bf16 v[16:31], v[116:117], v[106:107], 0
    v_exp_f32 v41, v41
    v_exp_f32 v42, v42
    v_exp_f32 v43, v43
    v_exp_f32 v44, v44
    v_smfmac_f32_32x32x32_bf16 v[64:79], v[120:123], v[32:39], v154
    v_exp_f32 v45, v45
    v_exp_f32 v46, v46
    v_exp_f32 v47, v47
    v_mfma_f32_32x32x16_bf16 v[0:15], v[108:111], v[96:99], v[0:15]
    v_exp_f32 v48, v48
    v_exp_f32 v49, v49
    v_exp_f32 v50, v50
    v_mfma_f32_32x32x16_bf16 v[16:31], v[108:111], v[100:103], v[16:31]
    v_exp_f32 v51, v51
    v_exp_f32 v52, v52
    v_exp_f32 v53, v53
    v_smfmac_f32_32x32x32_bf16 v[64:79], v[124:127], v[40:47], v154
    v_exp_f32 v54, v54
    v_exp_f32 v55, v55
    v_exp_f32 v56, v56
    v_exp_f32 v57, v57
    v_smfmac_f32_32x32x32_bf16 v[80:95], v[120:123], v[48:55], v154
    v_exp_f32 v58, v58
    v_exp_f32 v59, v59
    v_lshl_add_u64 v[136:137], v[136:137], 0, v[138:139]
    v_exp_f32 v60, v60
    v_exp_f32 v61, v61
    v_exp_f32 v62, v62
    v_exp_f32 v63, v63
    s_nop 1
    v_smfmac_f32_32x32x32_bf16 v[80:95], v[124:127], v[56:63], v154
    s_setprio 0
    s_cmp_lg_u32 s35, 15
    s_cbranch_scc1 L_LOOP
    s_mov_b32 exec_hi, 0
    ds_read2_b64 v[116:119], v159 offset0:4 offset1:164
    s_mov_b32 exec_hi, -1
    ds_read2_b64 v[108:111], v159 offset1:1
    ds_read2_b64 v[112:115], v159 offset0:160 offset1:161
    ds_read_b64_tr_b16 v[120:121], v137 offset:0
    ds_read_b64_tr_b16 v[122:123], v137 offset:160
    ds_read_b64_tr_b16 v[124:125], v137 offset:640
    ds_read_b64_tr_b16 v[126:127], v137 offset:800
    ds_read_b64_tr_b16 v[128:129], v160 offset:1280
    ds_read_b64_tr_b16 v[130:131], v160 offset:1440
    ds_read_b64_tr_b16 v[132:133], v160 offset:1920
    ds_read_b64_tr_b16 v[134:135], v160 offset:2080
    s_waitcnt lgkmcnt(0)
    v_exp_f32 v0, v0
    s_setprio 1
    v_exp_f32 v1, v1
    v_exp_f32 v2, v2
    v_exp_f32 v3, v3
    v_exp_f32 v4, v4
    v_mfma_f32_32x32x8_bf16 v[32:47], v[116:117], v[104:105], 0
    v_exp_f32 v5, v5
    v_exp_f32 v6, v6
    v_exp_f32 v7, v7
    v_exp_f32 v8, v8
    v_mfma_f32_32x32x8_bf16 v[48:63], v[118:119], v[104:105], 0
    v_exp_f32 v9, v9
    v_exp_f32 v10, v10
    v_exp_f32 v11, v11
    v_exp_f32 v12, v12
    v_smfmac_f32_32x32x32_bf16 v[64:79], v[120:123], v[0:7], v154
    v_exp_f32 v13, v13
    v_exp_f32 v14, v14
    v_exp_f32 v15, v15
    v_mfma_f32_32x32x16_bf16 v[32:47], v[108:111], v[96:99], v[32:47]
    v_exp_f32 v16, v16
    v_exp_f32 v17, v17
    v_exp_f32 v18, v18
    v_mfma_f32_32x32x16_bf16 v[48:63], v[112:115], v[96:99], v[48:63]
    v_exp_f32 v19, v19
    v_exp_f32 v20, v20
    v_exp_f32 v21, v21
    v_smfmac_f32_32x32x32_bf16 v[64:79], v[124:127], v[8:15], v154
    v_exp_f32 v22, v22
    v_exp_f32 v23, v23
    v_exp_f32 v24, v24
    v_exp_f32 v25, v25
    v_smfmac_f32_32x32x32_bf16 v[80:95], v[120:123], v[16:23], v154
    v_exp_f32 v26, v26
    v_exp_f32 v27, v27
    v_exp_f32 v28, v28
    v_exp_f32 v29, v29
    v_exp_f32 v30, v30
    v_exp_f32 v31, v31
    s_nop 1
    v_smfmac_f32_32x32x32_bf16 v[80:95], v[124:127], v[24:31], v154
    s_setprio 0
    ds_read_b64_tr_b16 v[120:121], v160 offset:0
    ds_read_b64_tr_b16 v[122:123], v160 offset:160
    ds_read_b64_tr_b16 v[124:125], v160 offset:640
    ds_read_b64_tr_b16 v[126:127], v160 offset:800
    s_mov_b32 s40, 0x71800000
    s_nop 5
    ds_write_b128 v158, v[80:83] offset:0
    ds_write_b128 v158, v[84:87] offset:1024
    ds_write_b128 v158, v[88:91] offset:2048
    s_cmp_lg_u32 s38, 0
    s_cbranch_scc1 L_FLAST
    s_waitcnt lgkmcnt(0)
    v_exp_f32 v32, v32
    s_setprio 1
    v_exp_f32 v33, v33
    v_exp_f32 v34, v34
    v_exp_f32 v35, v35
    v_exp_f32 v36, v36
    v_exp_f32 v37, v37
    v_exp_f32 v38, v38
    v_exp_f32 v39, v39
    v_exp_f32 v40, v40
    v_exp_f32 v41, v41
    v_exp_f32 v42, v42
    v_exp_f32 v43, v43
    v_exp_f32 v44, v44
    v_smfmac_f32_32x32x32_bf16 v[64:79], v[120:123], v[32:39], v154
    v_exp_f32 v45, v45
    v_exp_f32 v46, v46
    v_exp_f32 v47, v47
    v_exp_f32 v48, v48
    v_exp_f32 v49, v49
    v_exp_f32 v50, v50
    v_exp_f32 v51, v51
    v_exp_f32 v52, v52
    v_exp_f32 v53, v53
    v_smfmac_f32_32x32x32_bf16 v[64:79], v[124:127], v[40:47], v154
    v_exp_f32 v54, v54
    v_exp_f32 v55, v55
    v_exp_f32 v56, v56
    v_exp_f32 v57, v57
    v_exp_f32 v58, v58
    v_exp_f32 v59, v59
    v_exp_f32 v60, v60
    v_exp_f32 v61, v61
    v_exp_f32 v62, v62
    v_exp_f32 v63, v63
    v_smfmac_f32_32x32x32_bf16 v[64:79], v[128:131], v[48:55], v154
    s_barrier
    v_smfmac_f32_32x32x32_bf16 v[64:79], v[132:135], v[56:63], v154
    ds_read_b128 v[0:3], v157 offset:0
    ds_read_b128 v[4:7], v157 offset:1024
    ds_read_b128 v[8:11], v157 offset:2048
    s_setprio 2
    s_nop 5
    s_waitcnt lgkmcnt(0)
    s_branch L_FIN
L_FLAST:
    s_waitcnt lgkmcnt(0)
    s_barrier
    v_exp_f32 v32, v32
    s_setprio 1
    v_exp_f32 v33, v33
    v_exp_f32 v34, v34
    v_exp_f32 v35, v35
    v_exp_f32 v36, v36
    v_exp_f32 v37, v37
    v_exp_f32 v38, v38
    v_exp_f32 v39, v39
    v_exp_f32 v40, v40
    v_exp_f32 v41, v41
    v_exp_f32 v42, v42
    v_exp_f32 v43, v43
    v_exp_f32 v44, v44
    v_smfmac_f32_32x32x32_bf16 v[64:79], v[120:123], v[32:39], v154
    v_exp_f32 v45, v45
    v_exp_f32 v46, v46
    v_exp_f32 v47, v47
    ds_read_b128 v[0:3], v157 offset:0
    ds_read_b128 v[4:7], v157 offset:1024
    ds_read_b128 v[8:11], v157 offset:2048
    v_exp_f32 v48, v48
    v_exp_f32 v49, v49
    v_exp_f32 v50, v50
    v_exp_f32 v51, v51
    v_exp_f32 v52, v52
    v_exp_f32 v53, v53
    v_smfmac_f32_32x32x32_bf16 v[64:79], v[124:127], v[40:47], v154
    v_exp_f32 v54, v54
    v_exp_f32 v55, v55
    v_exp_f32 v56, v56
    v_exp_f32 v57, v57
    v_smfmac_f32_32x32x32_bf16 v[64:79], v[128:131], v[48:55], v154
    v_exp_f32 v58, v58
    v_exp_f32 v59, v59
    v_exp_f32 v60, v60
    v_exp_f32 v61, v61
    v_exp_f32 v62, v62
    v_exp_f32 v63, v63
    s_nop 1
    v_smfmac_f32_32x32x32_bf16 v[64:79], v[132:135], v[56:63], v154
    s_waitcnt lgkmcnt(0)
    s_nop 10
L_FIN:
    v_pk_add_f32 v[72:73], v[72:73], v[8:9]
    v_mov_b32 v76, v72
    v_pk_add_f32 v[64:65], v[64:65], v[0:1]
    v_pk_add_f32 v[66:67], v[66:67], v[2:3]
    v_pk_add_f32 v[68:69], v[68:69], v[4:5]
    v_pk_add_f32 v[70:71], v[70:71], v[6:7]
    v_pk_add_f32 v[74:75], v[74:75], v[10:11]
    v_permlane32_swap_b32 v72, v76
    v_rcp_f32 v144, v76
    v_cmp_le_f32 vcc, 1.0, v76
    v_pk_mul_f32 v[72:73], v[72:73], v[144:145] op_sel_hi:[1,0]
    v_pk_mul_f32 v[74:75], v[74:75], v[144:145] op_sel_hi:[1,0]
    v_pk_mul_f32 v[64:65], v[64:65], v[144:145] op_sel_hi:[1,0]
    v_pk_mul_f32 v[66:67], v[66:67], v[144:145] op_sel_hi:[1,0]
    v_pk_mul_f32 v[68:69], v[68:69], v[144:145] op_sel_hi:[1,0]
    v_pk_mul_f32 v[70:71], v[70:71], v[144:145] op_sel_hi:[1,0]
    v_cvt_pk_bf16_f32 v20, v72, v73
    v_cvt_pk_bf16_f32 v21, v74, v75
    v_cvt_pk_bf16_f32 v16, v64, v65
    v_cvt_pk_bf16_f32 v17, v66, v67
    v_cvt_pk_bf16_f32 v18, v68, v69
    v_cvt_pk_bf16_f32 v19, v70, v71
    ds_write_b64 v161, v[20:21] offset:32
    ds_write2_b64 v161, v[16:17], v[18:19] offset1:1
    ds_read_b128 v[24:27], v157
    ds_read_b32 v28, v162 offset:1024
    s_waitcnt lgkmcnt(1)
    buffer_store_dwordx4 v[24:27], v155, s[20:23], s49 offen sc0 sc1
    s_waitcnt lgkmcnt(0)
    buffer_store_dword v28, v163, s[20:23], s46 offen offset:1024 sc0 sc1
    s_setprio 0
    v_mov_b32 v149, 0
    v_dot2c_f32_bf16 v149, 0, v16
    v_dot2c_f32_bf16 v149, 0, v17
    v_dot2c_f32_bf16 v149, 0, v18
    v_dot2c_f32_bf16 v149, 0, v19
    v_dot2c_f32_bf16 v149, 0, v20
    v_dot2c_f32_bf16 v149, 0, v21
    v_cmp_ge_f32 s[42:43], s40, v76
    s_nop 1
    v_cmp_eq_f32 s[44:45], 0, v149
    s_and_b64 vcc, vcc, s[42:43]
    s_and_b64 vcc, vcc, s[44:45]
    s_cmp_eq_u64 vcc, -1
    s_cbranch_scc0 L_FALLBACK
L_DONE:
L_END:
    s_endpgm
L_FALLBACK:
    s_waitcnt vmcnt(0)
    s_mov_b64 s[24:25], s[4:5]
    s_mov_b64 s[26:27], s[14:15]
    s_mov_b64 s[28:29], s[6:7]
    s_mov_b64 s[30:31], s[14:15]
    v_mbcnt_lo_u32_b32 v145, -1, 0
    v_mbcnt_hi_u32_b32 v145, -1, v145
    v_and_b32 v146, 31, v145
    v_lshrrev_b32 v147, 5, v145
    v_add_u32 v152, s34, v152
    v_mul_u32_u24 v136, 40, v145
    v_add_u32 v136, s34, v136
    v_mul_u32_u24 v153, 320, v147
    v_bfe_u32 v148, v146, 2, 1
    v_lshl_add_u32 v153, v148, 4, v153
    v_bfe_u32 v148, v146, 3, 1
    v_lshl_add_u32 v153, v148, 3, v153
    v_bfe_u32 v148, v146, 4, 1
    v_lshl_add_u32 v153, v148, 5, v153
    v_and_b32 v148, 3, v146
    v_lshl_add_u32 v153, v148, 1, v153
    v_add_u32 v153, s34, v153
    v_cmp_gt_u32 s[50:51], 20, v146
    v_mov_b32 v120, 0x3f803f80
    v_mov_b32 v121, 0x3f803f80
    v_mov_b32 v122, 0x3f803f80
    v_mov_b32 v123, 0x3f803f80
    v_mov_b32 v124, 0x3f803f80
    v_mov_b32 v125, 0x3f803f80
    v_mov_b32 v126, 0x3f803f80
    v_mov_b32 v127, 0x3f803f80
    v_mov_b32 v128, 0x3f803f80
    v_mov_b32 v129, 0x3f803f80
    v_mov_b32 v130, 0x3f803f80
    v_mov_b32 v131, 0x3f803f80
    v_mov_b32 v132, 0x3f803f80
    v_mov_b32 v133, 0x3f803f80
    v_mov_b32 v134, 0x3f803f80
    v_mov_b32 v135, 0x3f803f80
    v_mov_b32 v64, 0
    v_mov_b32 v65, 0
    v_mov_b32 v66, 0
    v_mov_b32 v67, 0
    v_mov_b32 v68, 0
    v_mov_b32 v69, 0
    v_mov_b32 v70, 0
    v_mov_b32 v71, 0
    v_mov_b32 v72, 0
    v_mov_b32 v73, 0
    v_mov_b32 v74, 0
    v_mov_b32 v75, 0
    v_mov_b32 v76, 0
    v_mov_b32 v77, 0
    v_mov_b32 v78, 0
    v_mov_b32 v79, 0
    v_mov_b32 v149, 0xff800000
    s_mov_b32 s48, 0
L_FB_MAX:
    buffer_load_dwordx4 v[108:111], v152, s[24:27], s48 offen
    buffer_load_dwordx4 v[112:115], v152, s[24:27], s48 offen offset:1280
    buffer_load_dwordx2 v[116:117], v136, s[24:27], s48 offen offset:32
    s_waitcnt vmcnt(0)
    v_mfma_f32_32x32x16_bf16 v[0:15], v[108:111], v[96:99], 0
    v_mfma_f32_32x32x16_bf16 v[16:31], v[112:115], v[96:99], 0
    s_nop 9
    v_mfma_f32_32x32x4_2b_bf16 v[0:31], v[116:117], v[104:105], v[0:31] blgp:1
    s_nop 15
    s_nop 4
    v_max3_f32 v149, v0, v1, v149
    v_max3_f32 v149, v2, v3, v149
    v_max3_f32 v149, v4, v5, v149
    v_max3_f32 v149, v6, v7, v149
    v_max3_f32 v149, v8, v9, v149
    v_max3_f32 v149, v10, v11, v149
    v_max3_f32 v149, v12, v13, v149
    v_max3_f32 v149, v14, v15, v149
    v_max3_f32 v149, v16, v17, v149
    v_max3_f32 v149, v18, v19, v149
    v_max3_f32 v149, v20, v21, v149
    v_max3_f32 v149, v22, v23, v149
    v_max3_f32 v149, v24, v25, v149
    v_max3_f32 v149, v26, v27, v149
    v_max3_f32 v149, v28, v29, v149
    v_max3_f32 v149, v30, v31, v149
    s_add_u32 s48, s48, 2560
    s_cmp_lt_u32 s48, 81920
    s_cbranch_scc1 L_FB_MAX
    v_mov_b32 v150, v149
    s_nop 1
    v_permlane32_swap_b32 v149, v150
    s_nop 1
    v_max_f32 v149, v149, v150
    s_mov_b32 s48, 0
L_FB_PV:
    s_mov_b64 exec, s[50:51]
    buffer_load_ushort v32, v153, s[28:31], s48 offen offset:0
    buffer_load_ushort v33, v153, s[28:31], s48 offen offset:40
    buffer_load_ushort v34, v153, s[28:31], s48 offen offset:80
    buffer_load_ushort v35, v153, s[28:31], s48 offen offset:120
    buffer_load_ushort v36, v153, s[28:31], s48 offen offset:160
    buffer_load_ushort v37, v153, s[28:31], s48 offen offset:200
    buffer_load_ushort v38, v153, s[28:31], s48 offen offset:240
    buffer_load_ushort v39, v153, s[28:31], s48 offen offset:280
    buffer_load_ushort v40, v153, s[28:31], s48 offen offset:640
    buffer_load_ushort v41, v153, s[28:31], s48 offen offset:680
    buffer_load_ushort v42, v153, s[28:31], s48 offen offset:720
    buffer_load_ushort v43, v153, s[28:31], s48 offen offset:760
    buffer_load_ushort v44, v153, s[28:31], s48 offen offset:800
    buffer_load_ushort v45, v153, s[28:31], s48 offen offset:840
    buffer_load_ushort v46, v153, s[28:31], s48 offen offset:880
    buffer_load_ushort v47, v153, s[28:31], s48 offen offset:920
    buffer_load_ushort v48, v153, s[28:31], s48 offen offset:1280
    buffer_load_ushort v49, v153, s[28:31], s48 offen offset:1320
    buffer_load_ushort v50, v153, s[28:31], s48 offen offset:1360
    buffer_load_ushort v51, v153, s[28:31], s48 offen offset:1400
    buffer_load_ushort v52, v153, s[28:31], s48 offen offset:1440
    buffer_load_ushort v53, v153, s[28:31], s48 offen offset:1480
    buffer_load_ushort v54, v153, s[28:31], s48 offen offset:1520
    buffer_load_ushort v55, v153, s[28:31], s48 offen offset:1560
    buffer_load_ushort v56, v153, s[28:31], s48 offen offset:1920
    buffer_load_ushort v57, v153, s[28:31], s48 offen offset:1960
    buffer_load_ushort v58, v153, s[28:31], s48 offen offset:2000
    buffer_load_ushort v59, v153, s[28:31], s48 offen offset:2040
    buffer_load_ushort v60, v153, s[28:31], s48 offen offset:2080
    buffer_load_ushort v61, v153, s[28:31], s48 offen offset:2120
    buffer_load_ushort v62, v153, s[28:31], s48 offen offset:2160
    buffer_load_ushort v63, v153, s[28:31], s48 offen offset:2200
    s_waitcnt vmcnt(0)
    v_lshl_or_b32 v120, v33, 16, v32
    v_lshl_or_b32 v121, v35, 16, v34
    v_lshl_or_b32 v122, v37, 16, v36
    v_lshl_or_b32 v123, v39, 16, v38
    v_lshl_or_b32 v124, v41, 16, v40
    v_lshl_or_b32 v125, v43, 16, v42
    v_lshl_or_b32 v126, v45, 16, v44
    v_lshl_or_b32 v127, v47, 16, v46
    v_lshl_or_b32 v128, v49, 16, v48
    v_lshl_or_b32 v129, v51, 16, v50
    v_lshl_or_b32 v130, v53, 16, v52
    v_lshl_or_b32 v131, v55, 16, v54
    v_lshl_or_b32 v132, v57, 16, v56
    v_lshl_or_b32 v133, v59, 16, v58
    v_lshl_or_b32 v134, v61, 16, v60
    v_lshl_or_b32 v135, v63, 16, v62
    s_mov_b64 exec, -1
    buffer_load_dwordx4 v[108:111], v152, s[24:27], s48 offen
    buffer_load_dwordx4 v[112:115], v152, s[24:27], s48 offen offset:1280
    buffer_load_dwordx2 v[116:117], v136, s[24:27], s48 offen offset:32
    s_waitcnt vmcnt(0)
    v_mfma_f32_32x32x16_bf16 v[0:15], v[108:111], v[96:99], 0
    v_mfma_f32_32x32x16_bf16 v[16:31], v[112:115], v[96:99], 0
    s_nop 9
    v_mfma_f32_32x32x4_2b_bf16 v[0:31], v[116:117], v[104:105], v[0:31] blgp:1
    s_nop 15
    s_nop 4
    v_sub_f32 v0, v0, v149
    v_sub_f32 v1, v1, v149
    v_sub_f32 v2, v2, v149
    v_sub_f32 v3, v3, v149
    v_sub_f32 v4, v4, v149
    v_sub_f32 v5, v5, v149
    v_sub_f32 v6, v6, v149
    v_sub_f32 v7, v7, v149
    v_sub_f32 v8, v8, v149
    v_sub_f32 v9, v9, v149
    v_sub_f32 v10, v10, v149
    v_sub_f32 v11, v11, v149
    v_sub_f32 v12, v12, v149
    v_sub_f32 v13, v13, v149
    v_sub_f32 v14, v14, v149
    v_sub_f32 v15, v15, v149
    v_sub_f32 v16, v16, v149
    v_sub_f32 v17, v17, v149
    v_sub_f32 v18, v18, v149
    v_sub_f32 v19, v19, v149
    v_sub_f32 v20, v20, v149
    v_sub_f32 v21, v21, v149
    v_sub_f32 v22, v22, v149
    v_sub_f32 v23, v23, v149
    v_sub_f32 v24, v24, v149
    v_sub_f32 v25, v25, v149
    v_sub_f32 v26, v26, v149
    v_sub_f32 v27, v27, v149
    v_sub_f32 v28, v28, v149
    v_sub_f32 v29, v29, v149
    v_sub_f32 v30, v30, v149
    v_sub_f32 v31, v31, v149
    v_exp_f32 v0, v0
    v_exp_f32 v1, v1
    v_exp_f32 v2, v2
    v_exp_f32 v3, v3
    v_exp_f32 v4, v4
    v_exp_f32 v5, v5
    v_exp_f32 v6, v6
    v_exp_f32 v7, v7
    v_exp_f32 v8, v8
    v_exp_f32 v9, v9
    v_exp_f32 v10, v10
    v_exp_f32 v11, v11
    v_exp_f32 v12, v12
    v_exp_f32 v13, v13
    v_exp_f32 v14, v14
    v_exp_f32 v15, v15
    v_exp_f32 v16, v16
    v_exp_f32 v17, v17
    v_exp_f32 v18, v18
    v_exp_f32 v19, v19
    v_exp_f32 v20, v20
    v_exp_f32 v21, v21
    v_exp_f32 v22, v22
    v_exp_f32 v23, v23
    v_exp_f32 v24, v24
    v_exp_f32 v25, v25
    v_exp_f32 v26, v26
    v_exp_f32 v27, v27
    v_exp_f32 v28, v28
    v_exp_f32 v29, v29
    v_exp_f32 v30, v30
    v_exp_f32 v31, v31
    s_nop 1
    v_smfmac_f32_32x32x32_bf16 v[64:79], v[120:123], v[0:7], v154
    v_smfmac_f32_32x32x32_bf16 v[64:79], v[124:127], v[8:15], v154
    v_smfmac_f32_32x32x32_bf16 v[64:79], v[128:131], v[16:23], v154
    v_smfmac_f32_32x32x32_bf16 v[64:79], v[132:135], v[24:31], v154
    s_add_u32 s48, s48, 2560
    s_cmp_lt_u32 s48, 81920
    s_cbranch_scc1 L_FB_PV
    s_nop 15
    v_rcp_f32 v144, v76
    s_nop 0
    v_mul_f32 v64, v144, v64
    v_mul_f32 v65, v144, v65
    v_mul_f32 v66, v144, v66
    v_mul_f32 v67, v144, v67
    v_mul_f32 v68, v144, v68
    v_mul_f32 v69, v144, v69
    v_mul_f32 v70, v144, v70
    v_mul_f32 v71, v144, v71
    v_mul_f32 v72, v144, v72
    v_mul_f32 v73, v144, v73
    v_mul_f32 v74, v144, v74
    v_mul_f32 v75, v144, v75
    v_cvt_pk_bf16_f32 v32, v64, v65
    v_cvt_pk_bf16_f32 v33, v66, v67
    v_cvt_pk_bf16_f32 v34, v68, v69
    v_cvt_pk_bf16_f32 v35, v70, v71
    v_cvt_pk_bf16_f32 v36, v72, v73
    v_cvt_pk_bf16_f32 v37, v74, v75
    buffer_store_dwordx4 v[32:35], v156, s[20:23], 0 offen
    s_mov_b32 exec_hi, 0
    buffer_store_dwordx2 v[36:37], v156, s[20:23], 0 offen offset:32
    s_mov_b32 exec_hi, -1
    s_branch L_DONE
.section .rodata,"a"
.p2align 6
.amdhsa_kernel standalone__fused_io_aware_attn__prompt_kernel
  .amdhsa_next_free_vgpr 164
  .amdhsa_next_free_sgpr 64
  .amdhsa_accum_offset 164
  .amdhsa_group_segment_fixed_size 0
  .amdhsa_kernarg_size 48
  .amdhsa_user_sgpr_count 2
  .amdhsa_user_sgpr_kernarg_segment_ptr 1
  .amdhsa_system_sgpr_workgroup_id_x 1
.end_amdhsa_kernel
```
